```python
import torch

def _softmax(x, axis=-1):
    return torch.softmax(x, dim=axis)
def _gelu(x):
    return torch.nn.functional.gelu(x, approximate="tanh")
def _silu(x):
    return torch.nn.functional.silu(x)
def _sigmoid(x):
    return torch.sigmoid(x)
def _layernorm(x, axis=-1, eps=1e-5):
    m = x.mean(dim=axis, keepdim=True)
    v = x.var(dim=axis, keepdim=True, unbiased=False)
    return (x - m) / torch.sqrt(v + eps)
def _scatter_add(tgt, idx, src, axis=0):
    return tgt.clone().index_add_(axis, idx, src)
def _segment_sum(src, seg, n):
    out = torch.zeros((n,) + src.shape[1:], dtype=src.dtype)
    return out.index_add_(0, seg, src)
def _pad(x, pw):
    flat = tuple(v for pair in reversed(pw) for v in pair)
    return torch.nn.functional.pad(x, flat)

kernel_name = 'standalone__batchnorm__sampling'

def setup_inputs():

    _w = (lambda a: (lambda t: t.to(torch.bfloat16) if t.is_floating_point() else t)(torch.as_tensor(a)))
    B, S, C = 1024, 4, 512
    K = 3
    return {
        "x": _w((lambda *s: torch.randn(*s, dtype=torch.bfloat16) * 0.05)(B, S, C)),
        "w": _w((lambda *s: torch.randn(*s, dtype=torch.bfloat16) * 0.05)(K, C, C) * (1.0 / (K * C) ** 0.5)),
        "mean": _w((lambda *s: torch.randn(*s, dtype=torch.bfloat16) * 0.05)(C) * 0.1),
        "var": _w(torch.abs((lambda *s: torch.randn(*s, dtype=torch.bfloat16) * 0.05)(C)) + 0.5),
        "g": _w((lambda *s: torch.randn(*s, dtype=torch.bfloat16) * 0.05)(C) + 1.0),
        "b": _w((lambda *s: torch.randn(*s, dtype=torch.bfloat16) * 0.05)(C) * 0.1),
    }

def reference(x, w, mean, var, g, b):
    K = 3
    P = K // 2
    S = x.shape[1]
    xp = _pad(x, ((0, 0), (P, P), (0, 0)))
    y = sum(torch.einsum('bsc,cd->bsd', xp[:, k:k + S, :], w[k]) for k in range(K))
    inv_std = 1.0 / torch.sqrt(var + 1e-5)
    y = (y - mean) * (g * inv_std) + b
    return _silu(y)
```

```asm
; @launch grid=(256,1,1) block=(512,1,1) lds=139776
.amdgcn_target "amdgcn-amd-amdhsa--gfx950"
.text
.globl standalone__batchnorm__sampling_kernel
.p2align 8
.type standalone__batchnorm__sampling_kernel,@function
standalone__batchnorm__sampling_kernel:
    s_load_dwordx2 s[20:21], s[0:1], 0
    s_load_dwordx2 s[24:25], s[0:1], 8
    v_lshrrev_b32 v1, 6, v0
    s_cmp_ge_u32 s2, 256
    s_cbranch_scc1 L_end
    v_readfirstlane_b32 s35, v1
    s_lshr_b32 s36, s2, 5
    s_bfe_u32 s32, s2, 0x20003
    s_and_b32 s37, s2, 3
    s_lshl3_add_u32 s37, s37, s36
    s_lshl_b32 s37, s37, 17
    s_lshr_b32 s39, s2, 2
    s_and_b32 s39, s39, 1
    s_lshl2_add_u32 s39, s39, s32
    s_lshl_b32 s39, s39, 7
    s_lshr_b32 s47, s36, 2
    s_cmp_ge_u32 s35, 4
    s_cbranch_scc1 L_consumer
    s_load_dwordx8 s[8:15], s[0:1], 16
    s_add_u32 s3, s32, s36
    s_bitcmp1_b32 s3, 0
    s_mov_b32 s38, 0x5417263
    s_mov_b32 s44, 0x5174236
    s_cselect_b32 s38, 0x5124736, s38
    s_cselect_b32 s44, 0x1547326, s44
    s_bitcmp1_b32 s3, 1
    s_cselect_b32 s38, s44, s38
    v_lshlrev_b32 v4, 4, v0
    v_lshrrev_b32 v3, 3, v0
    v_xor_b32 v6, v4, v0
    v_and_b32 v6, 0x70, v6
    v_lshl_add_u32 v6, v3, 12, v6
    v_add_u32 v6, s37, v6
    v_lshlrev_b32 v5, 1, v0
    v_and_b32 v5, 32, v5
    v_and_or_b32 v5, v0, 64, v5
    v_xor_b32 v7, v4, v5
    v_and_b32 v7, 0x70, v7
    v_lshl_add_u32 v7, v3, 10, v7
    s_lshl_b32 s45, s47, 15
    s_add_u32 s46, s39, s45
    s_sub_u32 s3, s39, s45
    s_add_u32 s3, s3, 31744
    v_add_u32 v8, s3, v7
    v_add_u32 v7, s46, v7
    s_lshl_b32 s40, s35, 12
    s_lshr_b32 s41, s40, 1
    s_add_u32 s41, s41, 16384
    s_mov_b32 s22, 0x400000
    s_mov_b32 s23, 0x20000
    s_mov_b32 s26, 0x180000
    s_mov_b32 s27, s23
    s_and_b32 s44, s38, 7
    s_lshl_b32 s43, s44, 7
    s_mov_b32 m0, s40
    s_lshl_b32 s44, s44, 16
    s_waitcnt lgkmcnt(0)
    buffer_load_dwordx4 v6, s[20:23], s43 offen offset:0 lds
    s_mov_b32 m0, s41
    s_add_u32 s45, s44, 0x80000
    buffer_load_dwordx4 v7, s[24:27], s44 offen lds
    s_cmp_lg_u32 s35, 0
    s_cbranch_scc1 L_l1
    v_lshl_add_u32 v9, v0, 1, s39
    global_load_ushort v20, v9, s[8:9]
    global_load_ushort v21, v9, s[10:11]
    global_load_ushort v22, v9, s[12:13]
    global_load_ushort v23, v9, s[14:15]
L_l1:
    s_mov_b32 m0, s40
    s_nop 0
    buffer_load_dwordx4 v6, s[20:23], s43 offen offset:1024 lds
    buffer_load_dwordx4 v6, s[20:23], s43 offen offset:2048 lds
    buffer_load_dwordx4 v6, s[20:23], s43 offen offset:3072 lds
    s_add_u32 m0, s41, 8192
    s_add_u32 s46, s44, 0x100000
    buffer_load_dwordx4 v7, s[24:27], s45 offen lds
    s_add_u32 m0, s41, 16384
    s_lshr_b32 s38, s38, 4
    buffer_load_dwordx4 v7, s[24:27], s46 offen lds
    s_mov_b32 s42, 0
    s_mov_b32 s49, 40960
    s_mov_b32 s50, 0xfffec000
    s_mov_b32 s52, 122880
    s_add_u32 m0, s41, 8192
    s_add_u32 s40, s40, s49
    buffer_load_dwordx4 v8, s[24:27], s45 offen offset:1024 lds
    s_add_u32 m0, s41, 16384
    s_cmp_lt_u32 s40, s52
    buffer_load_dwordx4 v8, s[24:27], s46 offen offset:1024 lds
    s_mov_b32 m0, s41
    s_cselect_b32 s48, s49, s50
    buffer_load_dwordx4 v8, s[24:27], s44 offen offset:1024 lds
    s_cselect_b32 s51, 0, s52
    s_add_u32 s41, s41, s48
    s_sub_u32 s40, s40, s51
    s_cmp_lg_u32 s35, 0
    s_cbranch_scc1 L_lloop
    s_mov_b32 s3, 0x3727c5ac
    s_waitcnt vmcnt(8)
    v_lshlrev_b32 v21, 16, v21
    v_add_f32 v21, s3, v21
    v_cvt_pk_bf16_f32 v21, v21, v21
    v_lshlrev_b32 v21, 16, v21
    v_sqrt_f32 v21, v21
    v_lshlrev_b32 v22, 16, v22
    v_cvt_pk_bf16_f32 v21, v21, v21
    v_lshlrev_b32 v21, 16, v21
    v_rcp_f32 v21, v21
    v_lshlrev_b32 v20, 16, v20
    v_cvt_pk_bf16_f32 v21, v21, v21
    v_lshlrev_b32 v21, 16, v21
    v_mul_f32 v21, v22, v21
    v_cvt_pk_bf16_f32 v21, v21, v21
    v_lshlrev_b32 v21, 16, v21
    v_lshlrev_b32 v23, 16, v23
    v_fma_f32 v23, -v20, v21, v23
    v_mul_f32 v21, 0xbfb8aa3b, v21
    v_mul_f32 v23, 0xbfb8aa3b, v23
    v_lshl_add_u32 v9, v0, 2, s52
    ds_write2st64_b32 v9, v21, v23 offset0:0 offset1:1
L_lloop:
    s_and_b32 s44, s38, 7
    s_lshl_b32 s43, s44, 7
    s_mov_b32 m0, s40
    s_lshl_b32 s44, s44, 16
    buffer_load_dwordx4 v6, s[20:23], s43 offen offset:0 lds
    buffer_load_dwordx4 v6, s[20:23], s43 offen offset:1024 lds
    buffer_load_dwordx4 v6, s[20:23], s43 offen offset:2048 lds
    buffer_load_dwordx4 v6, s[20:23], s43 offen offset:3072 lds
    s_mov_b32 m0, s41
    s_add_u32 s45, s44, 0x80000
    buffer_load_dwordx4 v7, s[24:27], s44 offen lds
    s_add_u32 m0, s41, 8192
    s_add_u32 s46, s44, 0x100000
    buffer_load_dwordx4 v7, s[24:27], s45 offen lds
    s_add_u32 m0, s41, 16384
    s_lshr_b32 s38, s38, 4
    buffer_load_dwordx4 v7, s[24:27], s46 offen lds
    s_add_u32 s42, s42, 1
    s_cmp_lg_u32 s42, 1
    s_cbranch_scc1 L_l3
    s_waitcnt vmcnt(10) lgkmcnt(0)
    s_barrier
L_l3:
    s_waitcnt vmcnt(7)
    s_barrier
    s_add_u32 m0, s41, 8192
    s_add_u32 s40, s40, s49
    buffer_load_dwordx4 v8, s[24:27], s45 offen offset:1024 lds
    s_add_u32 m0, s41, 16384
    s_cmp_lt_u32 s40, s52
    buffer_load_dwordx4 v8, s[24:27], s46 offen offset:1024 lds
    s_mov_b32 m0, s41
    s_cselect_b32 s48, s49, s50
    buffer_load_dwordx4 v8, s[24:27], s44 offen offset:1024 lds
    s_cselect_b32 s51, 0, s52
    s_add_u32 s41, s41, s48
    s_sub_u32 s40, s40, s51
    s_cmp_lt_u32 s42, 7
    s_cbranch_scc1 L_lloop
    s_waitcnt vmcnt(3)
    s_barrier
    s_waitcnt vmcnt(0)
    s_barrier
    s_load_dwordx2 s[28:29], s[0:1], 48
    v_and_b32 v4, 0x70, v4
    v_lshl_add_u32 v10, v3, 12, v4
    s_add_u32 s3, s37, s39
    v_add_u32 v10, s3, v10
    v_lshlrev_b32 v5, 4, v3
    v_and_b32 v5, 0x70, v5
    v_xor_b32 v5, v5, v4
    v_lshl_add_u32 v11, v3, 7, v5
    v_add_u32 v11, 123392, v11
    s_mov_b32 s30, s22
    s_mov_b32 s31, s23
    s_barrier
    ds_read_b128 v[12:15], v11 offset:0
    s_waitcnt lgkmcnt(0)
    buffer_store_dwordx4 v[12:15], v10, s[28:31], 0 offen offset:0 sc1
    s_barrier
    ds_read_b128 v[16:19], v11 offset:4096
    s_waitcnt lgkmcnt(0)
    buffer_store_dwordx4 v[16:19], v10, s[28:31], 0 offen offset:1024 sc1
    s_barrier
    ds_read_b128 v[20:23], v11 offset:8192
    s_waitcnt lgkmcnt(0)
    buffer_store_dwordx4 v[20:23], v10, s[28:31], 0 offen offset:2048 sc1
    s_barrier
    ds_read_b128 v[24:27], v11 offset:12288
    s_waitcnt lgkmcnt(0)
    buffer_store_dwordx4 v[24:27], v10, s[28:31], 0 offen offset:3072 sc1
    s_endpgm
L_consumer:
    v_and_b32 v3, 15, v0
    v_bfe_u32 v4, v0, 4, 2
    s_and_b32 s36, s35, 1
    s_bfe_u32 s33, s35, 0x10001
    v_lshrrev_b32 v5, 3, v3
    v_lshlrev_b32 v5, 12, v5
    v_and_b32 v6, 7, v3
    v_lshl_add_u32 v5, v6, 7, v5
    v_lshrrev_b32 v6, 1, v3
    v_xor_b32 v6, v6, v4
    v_lshl_add_u32 v5, v6, 4, v5
    s_lshl_b32 s3, s36, 13
    v_add_u32 v10, s3, v5
    s_lshl_b32 s3, s47, 6
    v_xor_b32 v10, s3, v10
    v_xor_b32 v11, 64, v10
    v_lshrrev_b32 v5, 2, v3
    v_lshlrev_b32 v6, 11, v4
    v_lshl_add_u32 v6, v5, 7, v6
    v_lshrrev_b32 v5, 1, v5
    v_and_b32 v7, 1, v4
    v_lshl_add_u32 v5, v7, 1, v5
    s_lshl_b32 s3, s33, 1
    v_xor_b32 v5, s3, v5
    v_lshl_add_u32 v6, v5, 5, v6
    v_and_b32 v5, 3, v0
    v_lshl_add_u32 v6, v5, 3, v6
    v_add_u32 v12, 16384, v6
    v_xor_b32 v13, 32, v12
    v_lshrrev_b32 v5, 1, v4
    s_lshl_b32 s34, s33, 2
    v_add_u32 v5, s34, v5
    v_xor_b32 v5, v5, v3
    v_and_b32 v5, 7, v5
    v_lshlrev_b32 v5, 4, v5
    v_lshl_add_u32 v5, v7, 3, v5
    v_lshl_add_u32 v5, v3, 7, v5
    s_lshl_b32 s34, s36, 11
    s_add_u32 s34, s34, 123392
    v_add_u32 v15, s34, v5
    v_xor_b32 v16, 32, v15
    s_lshl_b32 s3, s33, 7
    s_add_u32 s3, s3, 122880
    v_lshl_add_u32 v8, v4, 4, s3
    s_mov_b32 s42, 0x24
    s_mov_b32 s46, 0
    s_mov_b32 s43, 40960
    s_mov_b32 s44, 0xfffec000
    s_mov_b32 s6, 0xbfb8aa3b
    s_mov_b32 s7, s6
    v_mov_b64 v[32:33], 0
    v_mov_b64 v[34:35], 0
    v_mov_b64 v[36:37], 0
    v_mov_b64 v[38:39], 0
    v_mov_b64 v[40:41], 0
    v_mov_b64 v[42:43], 0
    v_mov_b64 v[44:45], 0
    v_mov_b64 v[46:47], 0
    v_mov_b64 v[48:49], 0
    v_mov_b64 v[50:51], 0
    v_mov_b64 v[52:53], 0
    v_mov_b64 v[54:55], 0
    v_mov_b64 v[56:57], 0
    v_mov_b64 v[58:59], 0
    v_mov_b64 v[60:61], 0
    v_mov_b64 v[62:63], 0
    s_waitcnt lgkmcnt(0)
    s_barrier
    ds_read_b128 v[64:67], v8 offset:0
    ds_read_b128 v[68:71], v8 offset:64
    ds_read_b128 v[72:75], v8 offset:256
    ds_read_b128 v[76:79], v8 offset:320
    ds_read_b128 v[112:115], v10 offset:0
    ds_read_b64_tr_b16 v[128:129], v12 offset:0
    ds_read_b64_tr_b16 v[130:131], v12 offset:512
    ds_read_b64_tr_b16 v[132:133], v13 offset:0
    ds_read_b64_tr_b16 v[134:135], v13 offset:512
    ds_read_b64_tr_b16 v[136:137], v12 offset:8192
    ds_read_b64_tr_b16 v[138:139], v12 offset:8704
    ds_read_b64_tr_b16 v[140:141], v13 offset:8192
    ds_read_b64_tr_b16 v[142:143], v13 offset:8704
    ds_read_b128 v[116:119], v10 offset:1024
    ds_read_b64_tr_b16 v[144:145], v12 offset:16384
    ds_read_b64_tr_b16 v[146:147], v12 offset:16896
    ds_read_b64_tr_b16 v[148:149], v13 offset:16384
    ds_read_b64_tr_b16 v[150:151], v13 offset:16896
    ds_read_b128 v[120:123], v10 offset:2048
    ds_read_b128 v[124:127], v10 offset:3072
    s_barrier
    s_waitcnt lgkmcnt(6)
L_cloop:
    v_mfma_f32_16x16x32_bf16 v[40:43], v[128:131], v[112:115], v[40:43]
    ds_read_b128 v[152:155], v11 offset:0
    v_mfma_f32_16x16x32_bf16 v[44:47], v[132:135], v[112:115], v[44:47]
    ds_read_b64_tr_b16 v[168:169], v12 offset:1024
    v_mfma_f32_16x16x32_bf16 v[32:35], v[136:139], v[112:115], v[32:35]
    ds_read_b64_tr_b16 v[170:171], v12 offset:1536
    v_mfma_f32_16x16x32_bf16 v[36:39], v[140:143], v[112:115], v[36:39]
    ds_read_b64_tr_b16 v[172:173], v13 offset:1024
    v_mfma_f32_16x16x32_bf16 v[48:51], v[128:131], v[116:119], v[48:51]
    ds_read_b64_tr_b16 v[174:175], v13 offset:1536
    v_mfma_f32_16x16x32_bf16 v[52:55], v[132:135], v[116:119], v[52:55]
    ds_read_b64_tr_b16 v[176:177], v12 offset:9216
    v_mfma_f32_16x16x32_bf16 v[40:43], v[136:139], v[116:119], v[40:43]
    ds_read_b64_tr_b16 v[178:179], v12 offset:9728
    v_mfma_f32_16x16x32_bf16 v[44:47], v[140:143], v[116:119], v[44:47]
    s_waitcnt lgkmcnt(7)
    v_mfma_f32_16x16x32_bf16 v[32:35], v[144:147], v[116:119], v[32:35]
    ds_read_b64_tr_b16 v[180:181], v13 offset:9216
    v_mfma_f32_16x16x32_bf16 v[36:39], v[148:151], v[116:119], v[36:39]
    ds_read_b64_tr_b16 v[182:183], v13 offset:9728
    v_mfma_f32_16x16x32_bf16 v[56:59], v[128:131], v[120:123], v[56:59]
    ds_read_b128 v[156:159], v11 offset:1024
    v_mfma_f32_16x16x32_bf16 v[60:63], v[132:135], v[120:123], v[60:63]
    ds_read_b64_tr_b16 v[184:185], v12 offset:17408
    v_mfma_f32_16x16x32_bf16 v[48:51], v[136:139], v[120:123], v[48:51]
    ds_read_b64_tr_b16 v[186:187], v12 offset:17920
    v_mfma_f32_16x16x32_bf16 v[52:55], v[140:143], v[120:123], v[52:55]
    ds_read_b64_tr_b16 v[188:189], v13 offset:17408
    v_mfma_f32_16x16x32_bf16 v[40:43], v[144:147], v[120:123], v[40:43]
    ds_read_b64_tr_b16 v[190:191], v13 offset:17920
    v_mfma_f32_16x16x32_bf16 v[44:47], v[148:151], v[120:123], v[44:47]
    ds_read_b128 v[160:163], v11 offset:2048
    v_mfma_f32_16x16x32_bf16 v[56:59], v[136:139], v[124:127], v[56:59]
    ds_read_b128 v[164:167], v11 offset:3072
    v_mfma_f32_16x16x32_bf16 v[60:63], v[140:143], v[124:127], v[60:63]
    s_bitcmp1_b32 s42, s46
    v_mfma_f32_16x16x32_bf16 v[48:51], v[144:147], v[124:127], v[48:51]
    s_cselect_b32 s45, s44, s43
    v_mfma_f32_16x16x32_bf16 v[52:55], v[148:151], v[124:127], v[52:55]
    s_waitcnt lgkmcnt(2)
    v_mfma_f32_16x16x32_bf16 v[40:43], v[168:171], v[152:155], v[40:43]
    v_add_u32 v10, s45, v10
    v_mfma_f32_16x16x32_bf16 v[44:47], v[172:175], v[152:155], v[44:47]
    v_add_u32 v12, s45, v12
    v_mfma_f32_16x16x32_bf16 v[32:35], v[176:179], v[152:155], v[32:35]
    v_add_u32 v13, s45, v13
    v_mfma_f32_16x16x32_bf16 v[36:39], v[180:183], v[152:155], v[36:39]
    s_add_u32 s46, s46, 1
    s_cmp_lt_u32 s46, 7
    v_mfma_f32_16x16x32_bf16 v[48:51], v[168:171], v[156:159], v[48:51]
    v_add_u32 v11, s45, v11
    v_mfma_f32_16x16x32_bf16 v[52:55], v[172:175], v[156:159], v[52:55]
    s_waitcnt lgkmcnt(0)
    s_barrier
    v_mfma_f32_16x16x32_bf16 v[40:43], v[176:179], v[156:159], v[40:43]
    ds_read_b128 v[112:115], v10 offset:0
    ds_read_b64_tr_b16 v[128:129], v12 offset:0
    v_mfma_f32_16x16x32_bf16 v[44:47], v[180:183], v[156:159], v[44:47]
    ds_read_b64_tr_b16 v[130:131], v12 offset:512
    ds_read_b64_tr_b16 v[132:133], v13 offset:0
    v_mfma_f32_16x16x32_bf16 v[32:35], v[184:187], v[156:159], v[32:35]
    ds_read_b64_tr_b16 v[134:135], v13 offset:512
    ds_read_b64_tr_b16 v[136:137], v12 offset:8192
    v_mfma_f32_16x16x32_bf16 v[36:39], v[188:191], v[156:159], v[36:39]
    ds_read_b64_tr_b16 v[138:139], v12 offset:8704
    v_mfma_f32_16x16x32_bf16 v[56:59], v[168:171], v[160:163], v[56:59]
    ds_read_b64_tr_b16 v[140:141], v13 offset:8192
    v_mfma_f32_16x16x32_bf16 v[60:63], v[172:175], v[160:163], v[60:63]
    ds_read_b64_tr_b16 v[142:143], v13 offset:8704
    v_mfma_f32_16x16x32_bf16 v[48:51], v[176:179], v[160:163], v[48:51]
    ds_read_b128 v[116:119], v10 offset:1024
    v_mfma_f32_16x16x32_bf16 v[52:55], v[180:183], v[160:163], v[52:55]
    ds_read_b64_tr_b16 v[144:145], v12 offset:16384
    v_mfma_f32_16x16x32_bf16 v[40:43], v[184:187], v[160:163], v[40:43]
    ds_read_b64_tr_b16 v[146:147], v12 offset:16896
    v_mfma_f32_16x16x32_bf16 v[44:47], v[188:191], v[160:163], v[44:47]
    ds_read_b64_tr_b16 v[148:149], v13 offset:16384
    v_mfma_f32_16x16x32_bf16 v[56:59], v[176:179], v[164:167], v[56:59]
    ds_read_b64_tr_b16 v[150:151], v13 offset:16896
    v_mfma_f32_16x16x32_bf16 v[60:63], v[180:183], v[164:167], v[60:63]
    ds_read_b128 v[120:123], v10 offset:2048
    v_mfma_f32_16x16x32_bf16 v[48:51], v[184:187], v[164:167], v[48:51]
    ds_read_b128 v[124:127], v10 offset:3072
    v_mfma_f32_16x16x32_bf16 v[52:55], v[188:191], v[164:167], v[52:55]
    s_waitcnt lgkmcnt(6)
    s_cbranch_scc1 L_cloop
    v_mfma_f32_16x16x32_bf16 v[32:35], v[136:139], v[112:115], v[32:35]
    ds_read_b128 v[152:155], v11 offset:0
    v_mfma_f32_16x16x32_bf16 v[36:39], v[140:143], v[112:115], v[36:39]
    ds_read_b128 v[156:159], v11 offset:1024
    s_barrier
    s_waitcnt lgkmcnt(6)
    v_mfma_f32_16x16x32_bf16 v[32:35], v[144:147], v[116:119], v[32:35]
    ds_read_b64_tr_b16 v[176:177], v12 offset:9216
    ds_read_b64_tr_b16 v[178:179], v12 offset:9728
    s_waitcnt lgkmcnt(6)
    v_mfma_f32_16x16x32_bf16 v[36:39], v[148:151], v[116:119], v[36:39]
    ds_read_b64_tr_b16 v[180:181], v13 offset:9216
    ds_read_b64_tr_b16 v[182:183], v13 offset:9728
    v_mfma_f32_16x16x32_bf16 v[40:43], v[128:131], v[112:115], v[40:43]
    ds_read_b64_tr_b16 v[184:185], v12 offset:17408
    ds_read_b64_tr_b16 v[186:187], v12 offset:17920
    v_mfma_f32_16x16x32_bf16 v[44:47], v[132:135], v[112:115], v[44:47]
    ds_read_b64_tr_b16 v[188:189], v13 offset:17408
    ds_read_b64_tr_b16 v[190:191], v13 offset:17920
    v_mfma_f32_16x16x32_bf16 v[40:43], v[136:139], v[116:119], v[40:43]
    ds_read_b64_tr_b16 v[168:169], v12 offset:1024
    v_mfma_f32_16x16x32_bf16 v[44:47], v[140:143], v[116:119], v[44:47]
    ds_read_b64_tr_b16 v[170:171], v12 offset:1536
    s_waitcnt lgkmcnt(13)
    v_mfma_f32_16x16x32_bf16 v[40:43], v[144:147], v[120:123], v[40:43]
    ds_read_b64_tr_b16 v[172:173], v13 offset:1024
    v_mfma_f32_16x16x32_bf16 v[44:47], v[148:151], v[120:123], v[44:47]
    ds_read_b64_tr_b16 v[174:175], v13 offset:1536
    s_waitcnt lgkmcnt(10)
    v_mfma_f32_16x16x32_bf16 v[32:35], v[176:179], v[152:155], v[32:35]
    ds_read_b128 v[160:163], v11 offset:2048
    s_waitcnt lgkmcnt(9)
    v_mfma_f32_16x16x32_bf16 v[36:39], v[180:183], v[152:155], v[36:39]
    ds_read_b128 v[164:167], v11 offset:3072
    s_waitcnt lgkmcnt(8)
    v_mfma_f32_16x16x32_bf16 v[32:35], v[184:187], v[156:159], v[32:35]
    s_waitcnt lgkmcnt(6)
    v_mfma_f32_16x16x32_bf16 v[36:39], v[188:191], v[156:159], v[36:39]
    s_nop 1
    s_waitcnt lgkmcnt(4)
    v_mfma_f32_16x16x32_bf16 v[40:43], v[168:171], v[152:155], v[40:43]
    s_nop 1
    s_waitcnt lgkmcnt(2)
    v_mfma_f32_16x16x32_bf16 v[44:47], v[172:175], v[152:155], v[44:47]
    s_nop 1
    v_mfma_f32_16x16x32_bf16 v[40:43], v[176:179], v[156:159], v[40:43]
    v_fma_f32 v32, v32, v64, v72
    v_fma_f32 v33, v33, v65, v73
    v_mfma_f32_16x16x32_bf16 v[44:47], v[180:183], v[156:159], v[44:47]
    v_fma_f32 v34, v34, v66, v74
    v_fma_f32 v35, v35, v67, v75
    s_waitcnt lgkmcnt(1)
    v_mfma_f32_16x16x32_bf16 v[40:43], v[184:187], v[160:163], v[40:43]
    v_fma_f32 v36, v36, v68, v76
    v_fma_f32 v37, v37, v69, v77
    v_mfma_f32_16x16x32_bf16 v[44:47], v[188:191], v[160:163], v[44:47]
    v_fma_f32 v38, v38, v70, v78
    v_fma_f32 v39, v39, v71, v79
    v_mfma_f32_16x16x32_bf16 v[48:51], v[128:131], v[116:119], v[48:51]
    v_exp_f32 v80, v32
    v_mfma_f32_16x16x32_bf16 v[52:55], v[132:135], v[116:119], v[52:55]
    v_exp_f32 v81, v33
    v_mfma_f32_16x16x32_bf16 v[48:51], v[136:139], v[120:123], v[48:51]
    v_exp_f32 v82, v34
    v_mfma_f32_16x16x32_bf16 v[52:55], v[140:143], v[120:123], v[52:55]
    v_exp_f32 v83, v35
    v_mfma_f32_16x16x32_bf16 v[48:51], v[144:147], v[124:127], v[48:51]
    v_exp_f32 v84, v36
    v_mfma_f32_16x16x32_bf16 v[52:55], v[148:151], v[124:127], v[52:55]
    v_exp_f32 v85, v37
    v_mfma_f32_16x16x32_bf16 v[48:51], v[168:171], v[156:159], v[48:51]
    v_exp_f32 v86, v38
    v_mfma_f32_16x16x32_bf16 v[52:55], v[172:175], v[156:159], v[52:55]
    v_exp_f32 v87, v39
    v_mfma_f32_16x16x32_bf16 v[48:51], v[176:179], v[160:163], v[48:51]
    v_fma_f32 v80, v80, s6, s6
    v_fma_f32 v81, v81, s6, s6
    v_mfma_f32_16x16x32_bf16 v[52:55], v[180:183], v[160:163], v[52:55]
    v_fma_f32 v82, v82, s6, s6
    v_fma_f32 v83, v83, s6, s6
    s_waitcnt lgkmcnt(0)
    v_mfma_f32_16x16x32_bf16 v[48:51], v[184:187], v[164:167], v[48:51]
    v_fma_f32 v84, v84, s6, s6
    v_fma_f32 v85, v85, s6, s6
    v_mfma_f32_16x16x32_bf16 v[52:55], v[188:191], v[164:167], v[52:55]
    v_fma_f32 v86, v86, s6, s6
    v_fma_f32 v87, v87, s6, s6
    v_mfma_f32_16x16x32_bf16 v[56:59], v[128:131], v[120:123], v[56:59]
    v_rcp_f32 v80, v80
    v_mfma_f32_16x16x32_bf16 v[60:63], v[132:135], v[120:123], v[60:63]
    v_rcp_f32 v81, v81
    v_mfma_f32_16x16x32_bf16 v[56:59], v[136:139], v[124:127], v[56:59]
    v_rcp_f32 v82, v82
    v_mfma_f32_16x16x32_bf16 v[60:63], v[140:143], v[124:127], v[60:63]
    v_rcp_f32 v83, v83
    v_mfma_f32_16x16x32_bf16 v[56:59], v[168:171], v[160:163], v[56:59]
    v_rcp_f32 v84, v84
    v_mfma_f32_16x16x32_bf16 v[60:63], v[172:175], v[160:163], v[60:63]
    v_rcp_f32 v85, v85
    v_mfma_f32_16x16x32_bf16 v[56:59], v[176:179], v[164:167], v[56:59]
    v_rcp_f32 v86, v86
    v_mfma_f32_16x16x32_bf16 v[60:63], v[180:183], v[164:167], v[60:63]
    v_rcp_f32 v87, v87
    v_pk_mul_f32 v[32:33], v[32:33], v[80:81]
    v_pk_mul_f32 v[34:35], v[34:35], v[82:83]
    v_pk_mul_f32 v[36:37], v[36:37], v[84:85]
    v_pk_mul_f32 v[38:39], v[38:39], v[86:87]
    v_cvt_pk_bf16_f32 v96, v32, v33
    v_cvt_pk_bf16_f32 v97, v34, v35
    v_cvt_pk_bf16_f32 v98, v36, v37
    v_cvt_pk_bf16_f32 v99, v38, v39
    ds_write_b64 v15, v[96:97] offset:0
    ds_write_b64 v16, v[98:99] offset:0
    v_pk_fma_f32 v[40:41], v[40:41], v[64:65], v[72:73]
    v_pk_fma_f32 v[42:43], v[42:43], v[66:67], v[74:75]
    v_pk_fma_f32 v[44:45], v[44:45], v[68:69], v[76:77]
    v_pk_fma_f32 v[46:47], v[46:47], v[70:71], v[78:79]
    v_exp_f32 v88, v40
    v_exp_f32 v89, v41
    s_waitcnt lgkmcnt(0)
    s_barrier
    v_exp_f32 v90, v42
    v_exp_f32 v91, v43
    v_exp_f32 v92, v44
    v_exp_f32 v93, v45
    v_exp_f32 v94, v46
    v_exp_f32 v95, v47
    v_pk_fma_f32 v[88:89], v[88:89], s[6:7], s[6:7]
    v_pk_fma_f32 v[90:91], v[90:91], s[6:7], s[6:7]
    v_pk_fma_f32 v[92:93], v[92:93], s[6:7], s[6:7]
    v_pk_fma_f32 v[94:95], v[94:95], s[6:7], s[6:7]
    v_rcp_f32 v88, v88
    v_rcp_f32 v89, v89
    v_rcp_f32 v90, v90
    v_rcp_f32 v91, v91
    v_rcp_f32 v92, v92
    v_rcp_f32 v93, v93
    v_rcp_f32 v94, v94
    v_rcp_f32 v95, v95
    v_pk_mul_f32 v[40:41], v[40:41], v[88:89]
    v_pk_mul_f32 v[42:43], v[42:43], v[90:91]
    v_pk_mul_f32 v[44:45], v[44:45], v[92:93]
    v_pk_mul_f32 v[46:47], v[46:47], v[94:95]
    v_cvt_pk_bf16_f32 v100, v40, v41
    v_cvt_pk_bf16_f32 v101, v42, v43
    v_cvt_pk_bf16_f32 v102, v44, v45
    v_cvt_pk_bf16_f32 v103, v46, v47
    ds_write_b64 v15, v[100:101] offset:4096
    ds_write_b64 v16, v[102:103] offset:4096
    v_pk_fma_f32 v[48:49], v[48:49], v[64:65], v[72:73]
    v_pk_fma_f32 v[50:51], v[50:51], v[66:67], v[74:75]
    v_pk_fma_f32 v[52:53], v[52:53], v[68:69], v[76:77]
    v_pk_fma_f32 v[54:55], v[54:55], v[70:71], v[78:79]
    v_exp_f32 v80, v48
    v_exp_f32 v81, v49
    s_waitcnt lgkmcnt(0)
    s_barrier
    v_exp_f32 v82, v50
    v_exp_f32 v83, v51
    v_exp_f32 v84, v52
    v_exp_f32 v85, v53
    v_exp_f32 v86, v54
    v_exp_f32 v87, v55
    v_pk_fma_f32 v[80:81], v[80:81], s[6:7], s[6:7]
    v_pk_fma_f32 v[82:83], v[82:83], s[6:7], s[6:7]
    v_pk_fma_f32 v[84:85], v[84:85], s[6:7], s[6:7]
    v_pk_fma_f32 v[86:87], v[86:87], s[6:7], s[6:7]
    v_rcp_f32 v80, v80
    v_rcp_f32 v81, v81
    v_rcp_f32 v82, v82
    v_rcp_f32 v83, v83
    v_rcp_f32 v84, v84
    v_rcp_f32 v85, v85
    v_rcp_f32 v86, v86
    v_rcp_f32 v87, v87
    v_pk_mul_f32 v[48:49], v[48:49], v[80:81]
    v_pk_mul_f32 v[50:51], v[50:51], v[82:83]
    v_pk_mul_f32 v[52:53], v[52:53], v[84:85]
    v_pk_mul_f32 v[54:55], v[54:55], v[86:87]
    v_cvt_pk_bf16_f32 v104, v48, v49
    v_cvt_pk_bf16_f32 v105, v50, v51
    v_cvt_pk_bf16_f32 v106, v52, v53
    v_cvt_pk_bf16_f32 v107, v54, v55
    ds_write_b64 v15, v[104:105] offset:8192
    ds_write_b64 v16, v[106:107] offset:8192
    v_pk_fma_f32 v[56:57], v[56:57], v[64:65], v[72:73]
    v_pk_fma_f32 v[58:59], v[58:59], v[66:67], v[74:75]
    v_pk_fma_f32 v[60:61], v[60:61], v[68:69], v[76:77]
    v_pk_fma_f32 v[62:63], v[62:63], v[70:71], v[78:79]
    v_exp_f32 v88, v56
    v_exp_f32 v89, v57
    s_waitcnt lgkmcnt(0)
    s_barrier
    v_exp_f32 v90, v58
    v_exp_f32 v91, v59
    v_exp_f32 v92, v60
    v_exp_f32 v93, v61
    v_exp_f32 v94, v62
    v_exp_f32 v95, v63
    v_pk_fma_f32 v[88:89], v[88:89], s[6:7], s[6:7]
    v_pk_fma_f32 v[90:91], v[90:91], s[6:7], s[6:7]
    v_pk_fma_f32 v[92:93], v[92:93], s[6:7], s[6:7]
    v_pk_fma_f32 v[94:95], v[94:95], s[6:7], s[6:7]
    v_rcp_f32 v88, v88
    v_rcp_f32 v89, v89
    v_rcp_f32 v90, v90
    v_rcp_f32 v91, v91
    v_rcp_f32 v92, v92
    v_rcp_f32 v93, v93
    v_rcp_f32 v94, v94
    v_rcp_f32 v95, v95
    v_pk_mul_f32 v[56:57], v[56:57], v[88:89]
    v_pk_mul_f32 v[58:59], v[58:59], v[90:91]
    v_pk_mul_f32 v[60:61], v[60:61], v[92:93]
    v_pk_mul_f32 v[62:63], v[62:63], v[94:95]
    v_cvt_pk_bf16_f32 v108, v56, v57
    v_cvt_pk_bf16_f32 v109, v58, v59
    v_cvt_pk_bf16_f32 v110, v60, v61
    v_cvt_pk_bf16_f32 v111, v62, v63
    ds_write_b64 v15, v[108:109] offset:12288
    ds_write_b64 v16, v[110:111] offset:12288
    s_waitcnt lgkmcnt(0)
    s_barrier
L_end:
    s_endpgm
.section .rodata,"a"
.p2align 6
.amdhsa_kernel standalone__batchnorm__sampling_kernel
  .amdhsa_next_free_vgpr 192
  .amdhsa_next_free_sgpr 56
  .amdhsa_accum_offset 192
  .amdhsa_group_segment_fixed_size 0
  .amdhsa_kernarg_size 72
  .amdhsa_user_sgpr_count 2
  .amdhsa_user_sgpr_kernarg_segment_ptr 1
  .amdhsa_system_sgpr_workgroup_id_x 1
.end_amdhsa_kernel
```
